```python
import torch

def _softmax(x, axis=-1):
    return torch.softmax(x, dim=axis)
def _gelu(x):
    return torch.nn.functional.gelu(x, approximate="tanh")
def _silu(x):
    return torch.nn.functional.silu(x)
def _sigmoid(x):
    return torch.sigmoid(x)
def _layernorm(x, axis=-1, eps=1e-5):
    m = x.mean(dim=axis, keepdim=True)
    v = x.var(dim=axis, keepdim=True, unbiased=False)
    return (x - m) / torch.sqrt(v + eps)
def _scatter_add(tgt, idx, src, axis=0):
    return tgt.clone().index_add_(axis, idx, src)
def _segment_sum(src, seg, n):
    out = torch.zeros((n,) + src.shape[1:], dtype=src.dtype)
    return out.index_add_(0, seg, src)
def _pad(x, pw):
    flat = tuple(v for pair in reversed(pw) for v in pair)
    return torch.nn.functional.pad(x, flat)

kernel_name = 'recurrent_scan__sliding_block_cached__swiglu_ffn__decode'

def setup_inputs():

    _w = (lambda a: (lambda t: t.to(torch.bfloat16) if t.is_floating_point() else t)(torch.as_tensor(a)))
    def _A_setup():
        B, Sq, D = 4, 1, 512
        Hq, Hkv, Sk, Dh = 32, 8, 16384, 128
        assert Hq % Hkv == 0, (Hq, Hkv)
        return {
            "x": _w((lambda *s: torch.randn(*s, dtype=torch.bfloat16) * 0.05)(B, Sq, D)),
            "k_cache": _w((lambda *s: torch.randn(*s, dtype=torch.bfloat16) * 1.6)(B, Hkv, Sk, Dh)),
            "v_cache": _w((lambda *s: torch.randn(*s, dtype=torch.bfloat16) * 0.2)(B, Hkv, Sk, Dh)),
            "wq": _w((lambda *s: torch.randn(*s, dtype=torch.bfloat16) * 1.6)(D, Hq * Dh) * (D ** -0.5)),
            "wo": _w((lambda *s: torch.randn(*s, dtype=torch.bfloat16) * 0.2)(Hq * Dh, D) * ((Hq * Dh) ** -0.5)),
        }
    _A_in = _A_setup()

    def _B_setup():
        B, S, D, F = 4, 1, 512, 1792
        return {
            "x": _w((lambda *s: torch.randn(*s, dtype=torch.bfloat16) * 0.05)(B, S, D)),
            "w_gate": _w((lambda *s: torch.randn(*s, dtype=torch.bfloat16) * 0.1)(D, F)),
            "w_up": _w((lambda *s: torch.randn(*s, dtype=torch.bfloat16) * 0.1)(D, F)),
            "w_down": _w((lambda *s: torch.randn(*s, dtype=torch.bfloat16) * 0.1)(F, D)),
        }
    _B_in = _B_setup()

    return {
        "A_x": _A_in["x"],
        "A_k_cache": _A_in["k_cache"],
        "A_v_cache": _A_in["v_cache"],
        "A_wq": _A_in["wq"],
        "A_wo": _A_in["wo"],
        "B_x": _B_in["x"],
        "B_w_gate": _B_in["w_gate"],
        "B_w_up": _B_in["w_up"],
        "B_w_down": _B_in["w_down"],
    }

def reference(A_x, A_k_cache, A_v_cache, A_wq, A_wo, B_x, B_w_gate, B_w_up, B_w_down):
    def _A_ref(x, k_cache, v_cache, wq, wo):
        B, Sq, D = x.shape
        Hq, Dh = 32, 128
        Hkv, Sk = k_cache.shape[1], k_cache.shape[2]
        W = min(4096, max(256, Sk // 4))
        rep = Hq // Hkv
        q = (lambda x, *d: x.permute(*d))((x @ wq).reshape(B, Sq, Hq, Dh), 0, 2, 1, 3)
        k = (lambda x, n, axis: torch.repeat_interleave(x, n, dim=axis))(k_cache[:, :, Sk - W:, :], rep, axis=1)
        v = (lambda x, n, axis: torch.repeat_interleave(x, n, dim=axis))(v_cache[:, :, Sk - W:, :], rep, axis=1)
        scores = torch.einsum("bhqd,bhkd->bhqk", q, k) * (Dh ** -0.5)
        p = _softmax(scores, axis=-1)
        o = torch.einsum("bhqk,bhkd->bhqd", p, v)
        return (lambda x, *d: x.permute(*d))(o, 0, 2, 1, 3).reshape(B, Sq, Hq * Dh) @ wo

    def _B_ref(x, w_gate, w_up, w_down):
        g = _silu(x @ w_gate)
        u = x @ w_up
        return (g * u) @ w_down

    x = A_x
    xn = _layernorm(x, axis=-1)
    s = _A_ref(xn, A_k_cache, A_v_cache, A_wq, A_wo)
    g = _silu(_B_ref(xn, B_w_gate, B_w_up, B_w_down))
    return x + s * g
```

```asm
; @launch grid=(256,1,1) block=(640,1,1) lds=163840
.amdgcn_target "amdgcn-amd-amdhsa--gfx950"
.text
.globl recurrent_scan__sliding_block_cached__swiglu_ffn__decode_kernel
.p2align 8
.type recurrent_scan__sliding_block_cached__swiglu_ffn__decode_kernel,@function
recurrent_scan__sliding_block_cached__swiglu_ffn__decode_kernel:
L_start:
    s_load_dwordx16 s[16:31], s[0:1], 0
    s_load_dwordx8 s[32:39], s[0:1], 64
    s_lshr_b32 s5, s2, 3
    s_and_b32 s4, s2, 7
    s_and_b32 s13, s5, 7
    s_mul_i32 s13, s13, 33
    s_and_b32 s12, s5, 24
    s_or_b32 s12, s12, s4
    s_lshl_b32 s12, s12, 10
    s_or_b32 s12, s12, s13
    s_addk_i32 s12, 0x300
    s_lshl_b32 s12, s12, 12
    v_and_b32 v6, 56, v0
    v_sub_u32 v5, v0, v6
    v_lshlrev_b32 v6, 1, v6
    v_lshl_or_b32 v5, v5, 8, v6
    v_xor_b32 v5, s12, v5
    v_cmp_gt_u32 vcc, 0x200, v0
    s_cbranch_vccz L_aux
    s_waitcnt lgkmcnt(0)
    global_load_dwordx4 v[64:67], v5, s[18:19] offset:0 nt
    global_load_dwordx4 v[68:71], v5, s[18:19] offset:128 nt
    global_load_dwordx4 v[72:75], v5, s[18:19] offset:2048 nt
    global_load_dwordx4 v[76:79], v5, s[18:19] offset:2176 nt
    s_branch L_main
L_aux:
    v_and_b32 v3, 64, v0
    v_and_b32 v0, 63, v0
    s_and_b32 s6, s5, 3
    v_readfirstlane_b32 s3, v3
    s_lshr_b32 s7, s5, 2
    s_setprio 3
    v_lshrrev_b32 v1, 4, v0
    v_and_b32 v4, 3, v0
    v_bfe_u32 v5, v0, 2, 2
    v_add_u32 v7, s6, v5
    v_and_b32 v7, 3, v7
    v_lshl_or_b32 v6, v4, 2, v7
    v_lshl_or_b32 v6, v6, 4, v1
    v_lshlrev_b32 v6, 4, v6
    v_lshrrev_b32 v7, 3, v0
    v_and_b32 v8, 7, v0
    v_and_b32 v9, 2, v7
    v_xor_b32 v8, v8, v9
    v_lshlrev_b32 v10, 4, v8
    s_lshr_b32 s12, s4, 1
    s_xor_b32 s12, s12, 3
    s_and_b32 s13, s4, 1
    s_lshl_b32 s13, s13, 2
    s_or_b32 s12, s12, s13
    s_and_b32 s13, s5, 24
    s_xor_b32 s13, s13, 16
    s_add_u32 s12, s12, s13
    s_mov_b32 s57, s12
    s_lshl_b32 s13, s4, 3
    s_add_u32 s13, s13, s7
    s_movk_i32 s8, 0xe00
    s_movk_i32 s14, 0x70
    s_cmp_eq_u32 s3, 0
    s_cselect_b32 s12, s13, s12
    s_cmovk_i32 s8, 0x2000
    s_cmovk_i32 s14, 0x60
    s_cmovk_i32 s57, 0
    s_lshl_b32 s11, s14, 10
    s_mul_i32 s14, s6, s8
    s_add_u32 s12, s12, s14
    s_lshl_b32 s12, s12, 7
    s_mul_i32 s46, s8, 0x7f
    s_addk_i32 s46, 0x80
    s_cmp_lt_u32 s57, 28
    s_cselect_b32 s46, s46, 0
    v_mad_u32_u24 v10, v7, s8, v10
    s_mov_b32 s47, 0x20000
    s_mov_b32 m0, s11
    s_lshl_b32 s13, s8, 3
    v_xor_b32 v11, 64, v10
    s_waitcnt lgkmcnt(0)
    global_load_dwordx4 v[16:19], v6, s[16:17]
    global_load_dwordx4 v[20:23], v6, s[16:17] offset:64
    global_load_dwordx4 v[24:27], v6, s[16:17] offset:128
    global_load_dwordx4 v[28:31], v6, s[16:17] offset:192
    s_bitcmp1_b32 s5, 2
    s_cselect_b64 s[44:45], s[30:31], s[28:29]
    s_cmp_eq_u32 s3, 0
    s_cselect_b64 s[44:45], s[22:23], s[44:45]
    s_add_u32 s44, s44, s12
    s_addc_u32 s45, s45, 0
    s_mov_b32 s12, 0
    s_lshl_b32 s14, s13, 4
    s_cmp_ge_u32 s2, 256
    s_cbranch_scc1 L_end
L_wl:
    buffer_load_dwordx4 v10, s[44:47], s12 offen nt lds
    s_add_u32 m0, m0, 1024
    s_add_u32 s12, s12, s13
    buffer_load_dwordx4 v11, s[44:47], s12 offen nt lds
    s_add_u32 m0, m0, 1024
    s_add_u32 s12, s12, s13
    s_cmp_lt_u32 s12, s14
    s_cbranch_scc1 L_wl
    s_lshr_b32 s3, s3, 6
    v_mov_b32 v2, 160768
    v_mov_b32 v12, 0
    v_mov_b32 v13, 0xff800000
    v_lshrrev_b32 v9, 2, v0
    v_cmp_eq_u32 vcc, 2, v9
    v_lshl_add_u32 v9, v0, 2, v2
    s_mov_b32 s15, 0x200000
    v_cndmask_b32 v12, v12, v13, vcc
    s_mov_b64 exec, 0xffff
    ds_write_b32 v9, v12
    s_mov_b64 exec, -1
    s_mov_b32 s42, 2162688
    s_mov_b32 s43, 0x20000
    s_mov_b32 s51, 0x20000
    s_lshl_b32 s9, s4, 15
    s_lshl_b32 s12, s6, 11
    s_add_u32 s9, s9, s12
    s_lshl_b32 s12, s7, 8
    s_add_u32 s9, s9, s12
    s_lshl_b32 s12, s57, 3
    s_and_b32 s13, s5, 7
    s_add_u32 s12, s12, s13
    s_lshl_b32 s12, s12, 10
    s_add_u32 s12, s12, 262144
    s_movk_i32 s10, 0x100
    s_cmp_eq_u32 s3, 0
    s_cselect_b32 s9, s9, s12
    s_cmovk_i32 s10, 0x2000
    s_cmp_lt_u32 s57, 28
    s_cselect_b32 s54, 2162688, 0
    s_getpc_b64 s[58:59]
L_pc:
    s_lshl_b32 s12, s5, 1
    s_add_u32 s12, s12, s3
    s_and_b32 s12, s12, 15
    s_lshl_b32 s12, s12, 10
    s_sub_u32 s58, s58, L_pc-L_start
    s_subb_u32 s59, s59, 0
    v_lshlrev_b32 v12, 4, v0
    v_add_u32 v12, s12, v12
    v_min_u32 v12, L_end-L_start-16, v12
    global_load_dwordx4 v[124:127], v12, s[58:59]
    s_waitcnt lgkmcnt(0)
    s_barrier
    s_load_dword s56, s[38:39], 520192
    s_mov_b32 s40, s38
    s_mov_b32 s41, s39
    s_mov_b32 s52, s38
    s_mov_b32 s53, s39
    s_mov_b32 s55, 0x20000
    s_waitcnt vmcnt(17)
    v_lshlrev_b32 v32, 16, v16
    v_and_b32 v33, 0xffff0000, v16
    v_lshlrev_b32 v34, 16, v17
    v_and_b32 v35, 0xffff0000, v17
    v_lshlrev_b32 v36, 16, v18
    v_and_b32 v37, 0xffff0000, v18
    v_lshlrev_b32 v38, 16, v19
    v_and_b32 v39, 0xffff0000, v19
    v_lshlrev_b32 v40, 16, v20
    v_and_b32 v41, 0xffff0000, v20
    v_lshlrev_b32 v42, 16, v21
    v_and_b32 v43, 0xffff0000, v21
    v_lshlrev_b32 v44, 16, v22
    v_and_b32 v45, 0xffff0000, v22
    v_lshlrev_b32 v46, 16, v23
    v_and_b32 v47, 0xffff0000, v23
    v_lshlrev_b32 v48, 16, v24
    v_and_b32 v49, 0xffff0000, v24
    v_lshlrev_b32 v50, 16, v25
    v_and_b32 v51, 0xffff0000, v25
    v_lshlrev_b32 v52, 16, v26
    v_and_b32 v53, 0xffff0000, v26
    v_lshlrev_b32 v54, 16, v27
    v_and_b32 v55, 0xffff0000, v27
    v_lshlrev_b32 v56, 16, v28
    v_and_b32 v57, 0xffff0000, v28
    v_lshlrev_b32 v58, 16, v29
    v_and_b32 v59, 0xffff0000, v29
    v_lshlrev_b32 v60, 16, v30
    v_and_b32 v61, 0xffff0000, v30
    v_lshlrev_b32 v62, 16, v31
    v_and_b32 v63, 0xffff0000, v31
    v_pk_add_f32 v[8:9], v[32:33], v[34:35]
    v_pk_add_f32 v[12:13], v[36:37], v[38:39]
    v_pk_add_f32 v[8:9], v[8:9], v[40:41]
    v_pk_add_f32 v[12:13], v[12:13], v[42:43]
    v_pk_add_f32 v[8:9], v[8:9], v[44:45]
    v_pk_add_f32 v[12:13], v[12:13], v[46:47]
    v_pk_add_f32 v[8:9], v[8:9], v[48:49]
    v_pk_add_f32 v[12:13], v[12:13], v[50:51]
    v_pk_add_f32 v[8:9], v[8:9], v[52:53]
    v_pk_add_f32 v[12:13], v[12:13], v[54:55]
    v_pk_add_f32 v[8:9], v[8:9], v[56:57]
    v_pk_add_f32 v[12:13], v[12:13], v[58:59]
    v_pk_add_f32 v[8:9], v[8:9], v[60:61]
    v_pk_add_f32 v[12:13], v[12:13], v[62:63]
    v_pk_add_f32 v[8:9], v[8:9], v[12:13]
    s_nop 0
    v_add_f32 v8, v8, v9
    s_nop 1
    v_add_f32_dpp v8, v8, v8 row_ror:4 row_mask:0xf bank_mask:0xf
    s_nop 1
    v_add_f32_dpp v8, v8, v8 row_ror:8 row_mask:0xf bank_mask:0xf
    v_mov_b32 v9, v8
    s_nop 1
    v_permlane16_swap_b32 v9, v8
    v_add_f32 v8, v8, v9
    v_mov_b32 v9, v8
    s_nop 1
    v_permlane32_swap_b32 v9, v8
    v_add_f32 v8, v8, v9
    v_mul_f32 v8, 0x3b000000, v8
    v_mov_b32 v14, 0
    v_mov_b32 v15, 0
    v_pk_add_f32 v[12:13], v[32:33], v[8:9] op_sel_hi:[1,0] neg_lo:[0,1] neg_hi:[0,1]
    v_pk_fma_f32 v[14:15], v[12:13], v[12:13], v[14:15]
    v_pk_add_f32 v[64:65], v[34:35], v[8:9] op_sel_hi:[1,0] neg_lo:[0,1] neg_hi:[0,1]
    v_pk_fma_f32 v[14:15], v[64:65], v[64:65], v[14:15]
    v_pk_add_f32 v[12:13], v[36:37], v[8:9] op_sel_hi:[1,0] neg_lo:[0,1] neg_hi:[0,1]
    v_pk_fma_f32 v[14:15], v[12:13], v[12:13], v[14:15]
    v_pk_add_f32 v[64:65], v[38:39], v[8:9] op_sel_hi:[1,0] neg_lo:[0,1] neg_hi:[0,1]
    v_pk_fma_f32 v[14:15], v[64:65], v[64:65], v[14:15]
    v_pk_add_f32 v[12:13], v[40:41], v[8:9] op_sel_hi:[1,0] neg_lo:[0,1] neg_hi:[0,1]
    v_pk_fma_f32 v[14:15], v[12:13], v[12:13], v[14:15]
    v_pk_add_f32 v[64:65], v[42:43], v[8:9] op_sel_hi:[1,0] neg_lo:[0,1] neg_hi:[0,1]
    v_pk_fma_f32 v[14:15], v[64:65], v[64:65], v[14:15]
    v_pk_add_f32 v[12:13], v[44:45], v[8:9] op_sel_hi:[1,0] neg_lo:[0,1] neg_hi:[0,1]
    v_pk_fma_f32 v[14:15], v[12:13], v[12:13], v[14:15]
    v_pk_add_f32 v[64:65], v[46:47], v[8:9] op_sel_hi:[1,0] neg_lo:[0,1] neg_hi:[0,1]
    v_pk_fma_f32 v[14:15], v[64:65], v[64:65], v[14:15]
    v_pk_add_f32 v[12:13], v[48:49], v[8:9] op_sel_hi:[1,0] neg_lo:[0,1] neg_hi:[0,1]
    v_pk_fma_f32 v[14:15], v[12:13], v[12:13], v[14:15]
    v_pk_add_f32 v[64:65], v[50:51], v[8:9] op_sel_hi:[1,0] neg_lo:[0,1] neg_hi:[0,1]
    v_pk_fma_f32 v[14:15], v[64:65], v[64:65], v[14:15]
    v_pk_add_f32 v[12:13], v[52:53], v[8:9] op_sel_hi:[1,0] neg_lo:[0,1] neg_hi:[0,1]
    v_pk_fma_f32 v[14:15], v[12:13], v[12:13], v[14:15]
    v_pk_add_f32 v[64:65], v[54:55], v[8:9] op_sel_hi:[1,0] neg_lo:[0,1] neg_hi:[0,1]
    v_pk_fma_f32 v[14:15], v[64:65], v[64:65], v[14:15]
    v_pk_add_f32 v[12:13], v[56:57], v[8:9] op_sel_hi:[1,0] neg_lo:[0,1] neg_hi:[0,1]
    v_pk_fma_f32 v[14:15], v[12:13], v[12:13], v[14:15]
    v_pk_add_f32 v[64:65], v[58:59], v[8:9] op_sel_hi:[1,0] neg_lo:[0,1] neg_hi:[0,1]
    v_pk_fma_f32 v[14:15], v[64:65], v[64:65], v[14:15]
    v_pk_add_f32 v[12:13], v[60:61], v[8:9] op_sel_hi:[1,0] neg_lo:[0,1] neg_hi:[0,1]
    v_pk_fma_f32 v[14:15], v[12:13], v[12:13], v[14:15]
    v_pk_add_f32 v[64:65], v[62:63], v[8:9] op_sel_hi:[1,0] neg_lo:[0,1] neg_hi:[0,1]
    v_pk_fma_f32 v[14:15], v[64:65], v[64:65], v[14:15]
    v_add_f32 v14, v14, v15
    s_nop 1
    v_add_f32_dpp v14, v14, v14 row_ror:4 row_mask:0xf bank_mask:0xf
    s_nop 1
    v_add_f32_dpp v14, v14, v14 row_ror:8 row_mask:0xf bank_mask:0xf
    v_mov_b32 v15, v14
    s_nop 1
    v_permlane16_swap_b32 v15, v14
    v_add_f32 v14, v14, v15
    v_mov_b32 v15, v14
    s_nop 1
    v_permlane32_swap_b32 v15, v14
    v_add_f32 v14, v14, v15
    v_mul_f32 v14, 0x3b000000, v14
    v_cvt_pk_bf16_f32 v14, 0, v14
    v_add_f32 v14, 0x3727c5ac, v14
    v_cvt_pk_bf16_f32 v14, 0, v14
    v_sqrt_f32 v14, v14
    s_nop 0
    v_cvt_pk_bf16_f32 v14, 0, v14
    v_rcp_f32 v14, v14
    v_cvt_pk_bf16_f32 v8, 0, v8
    v_pk_add_f32 v[32:33], v[32:33], v[8:9] op_sel_hi:[1,0] neg_lo:[0,1] neg_hi:[0,1]
    v_pk_add_f32 v[34:35], v[34:35], v[8:9] op_sel_hi:[1,0] neg_lo:[0,1] neg_hi:[0,1]
    v_pk_add_f32 v[36:37], v[36:37], v[8:9] op_sel_hi:[1,0] neg_lo:[0,1] neg_hi:[0,1]
    v_pk_add_f32 v[38:39], v[38:39], v[8:9] op_sel_hi:[1,0] neg_lo:[0,1] neg_hi:[0,1]
    v_pk_add_f32 v[40:41], v[40:41], v[8:9] op_sel_hi:[1,0] neg_lo:[0,1] neg_hi:[0,1]
    v_pk_add_f32 v[42:43], v[42:43], v[8:9] op_sel_hi:[1,0] neg_lo:[0,1] neg_hi:[0,1]
    v_pk_add_f32 v[44:45], v[44:45], v[8:9] op_sel_hi:[1,0] neg_lo:[0,1] neg_hi:[0,1]
    v_pk_add_f32 v[46:47], v[46:47], v[8:9] op_sel_hi:[1,0] neg_lo:[0,1] neg_hi:[0,1]
    v_pk_add_f32 v[48:49], v[48:49], v[8:9] op_sel_hi:[1,0] neg_lo:[0,1] neg_hi:[0,1]
    v_pk_add_f32 v[50:51], v[50:51], v[8:9] op_sel_hi:[1,0] neg_lo:[0,1] neg_hi:[0,1]
    v_pk_add_f32 v[52:53], v[52:53], v[8:9] op_sel_hi:[1,0] neg_lo:[0,1] neg_hi:[0,1]
    v_pk_add_f32 v[54:55], v[54:55], v[8:9] op_sel_hi:[1,0] neg_lo:[0,1] neg_hi:[0,1]
    v_pk_add_f32 v[56:57], v[56:57], v[8:9] op_sel_hi:[1,0] neg_lo:[0,1] neg_hi:[0,1]
    v_pk_add_f32 v[58:59], v[58:59], v[8:9] op_sel_hi:[1,0] neg_lo:[0,1] neg_hi:[0,1]
    v_pk_add_f32 v[60:61], v[60:61], v[8:9] op_sel_hi:[1,0] neg_lo:[0,1] neg_hi:[0,1]
    v_pk_add_f32 v[62:63], v[62:63], v[8:9] op_sel_hi:[1,0] neg_lo:[0,1] neg_hi:[0,1]
    v_cvt_pk_bf16_f32 v16, v32, v33
    v_cvt_pk_bf16_f32 v17, v34, v35
    v_cvt_pk_bf16_f32 v18, v36, v37
    v_cvt_pk_bf16_f32 v19, v38, v39
    v_cvt_pk_bf16_f32 v20, v40, v41
    v_cvt_pk_bf16_f32 v21, v42, v43
    v_cvt_pk_bf16_f32 v22, v44, v45
    v_cvt_pk_bf16_f32 v23, v46, v47
    v_cvt_pk_bf16_f32 v24, v48, v49
    v_cvt_pk_bf16_f32 v25, v50, v51
    v_cvt_pk_bf16_f32 v26, v52, v53
    v_cvt_pk_bf16_f32 v27, v54, v55
    v_cvt_pk_bf16_f32 v28, v56, v57
    v_cvt_pk_bf16_f32 v29, v58, v59
    v_cvt_pk_bf16_f32 v30, v60, v61
    v_cvt_pk_bf16_f32 v31, v62, v63
    v_lshlrev_b32 v32, 16, v16
    v_and_b32 v33, 0xffff0000, v16
    v_lshlrev_b32 v34, 16, v17
    v_and_b32 v35, 0xffff0000, v17
    v_lshlrev_b32 v36, 16, v18
    v_and_b32 v37, 0xffff0000, v18
    v_lshlrev_b32 v38, 16, v19
    v_and_b32 v39, 0xffff0000, v19
    v_lshlrev_b32 v40, 16, v20
    v_and_b32 v41, 0xffff0000, v20
    v_lshlrev_b32 v42, 16, v21
    v_and_b32 v43, 0xffff0000, v21
    v_lshlrev_b32 v44, 16, v22
    v_and_b32 v45, 0xffff0000, v22
    v_lshlrev_b32 v46, 16, v23
    v_and_b32 v47, 0xffff0000, v23
    v_lshlrev_b32 v48, 16, v24
    v_and_b32 v49, 0xffff0000, v24
    v_lshlrev_b32 v50, 16, v25
    v_and_b32 v51, 0xffff0000, v25
    v_lshlrev_b32 v52, 16, v26
    v_and_b32 v53, 0xffff0000, v26
    v_lshlrev_b32 v54, 16, v27
    v_and_b32 v55, 0xffff0000, v27
    v_lshlrev_b32 v56, 16, v28
    v_and_b32 v57, 0xffff0000, v28
    v_lshlrev_b32 v58, 16, v29
    v_and_b32 v59, 0xffff0000, v29
    v_lshlrev_b32 v60, 16, v30
    v_and_b32 v61, 0xffff0000, v30
    v_lshlrev_b32 v62, 16, v31
    v_and_b32 v63, 0xffff0000, v31
    v_pk_mul_f32 v[32:33], v[32:33], v[14:15] op_sel_hi:[1,0]
    v_pk_mul_f32 v[34:35], v[34:35], v[14:15] op_sel_hi:[1,0]
    v_pk_mul_f32 v[36:37], v[36:37], v[14:15] op_sel_hi:[1,0]
    v_pk_mul_f32 v[38:39], v[38:39], v[14:15] op_sel_hi:[1,0]
    v_pk_mul_f32 v[40:41], v[40:41], v[14:15] op_sel_hi:[1,0]
    v_pk_mul_f32 v[42:43], v[42:43], v[14:15] op_sel_hi:[1,0]
    v_pk_mul_f32 v[44:45], v[44:45], v[14:15] op_sel_hi:[1,0]
    v_pk_mul_f32 v[46:47], v[46:47], v[14:15] op_sel_hi:[1,0]
    v_pk_mul_f32 v[48:49], v[48:49], v[14:15] op_sel_hi:[1,0]
    v_pk_mul_f32 v[50:51], v[50:51], v[14:15] op_sel_hi:[1,0]
    v_pk_mul_f32 v[52:53], v[52:53], v[14:15] op_sel_hi:[1,0]
    v_pk_mul_f32 v[54:55], v[54:55], v[14:15] op_sel_hi:[1,0]
    v_pk_mul_f32 v[56:57], v[56:57], v[14:15] op_sel_hi:[1,0]
    v_pk_mul_f32 v[58:59], v[58:59], v[14:15] op_sel_hi:[1,0]
    v_pk_mul_f32 v[60:61], v[60:61], v[14:15] op_sel_hi:[1,0]
    v_pk_mul_f32 v[62:63], v[62:63], v[14:15] op_sel_hi:[1,0]
    v_cvt_pk_bf16_f32 v16, v32, v33
    v_cvt_pk_bf16_f32 v17, v34, v35
    v_cvt_pk_bf16_f32 v18, v36, v37
    v_cvt_pk_bf16_f32 v19, v38, v39
    v_cvt_pk_bf16_f32 v20, v40, v41
    v_cvt_pk_bf16_f32 v21, v42, v43
    v_cvt_pk_bf16_f32 v22, v44, v45
    v_cvt_pk_bf16_f32 v23, v46, v47
    v_cvt_pk_bf16_f32 v24, v48, v49
    v_cvt_pk_bf16_f32 v25, v50, v51
    v_cvt_pk_bf16_f32 v26, v52, v53
    v_cvt_pk_bf16_f32 v27, v54, v55
    v_cvt_pk_bf16_f32 v28, v56, v57
    v_cvt_pk_bf16_f32 v29, v58, v59
    v_cvt_pk_bf16_f32 v30, v60, v61
    v_cvt_pk_bf16_f32 v31, v62, v63
    v_lshlrev_b32 v8, 3, v1
    v_add_u32 v8, v8, v5
    v_lshlrev_b32 v8, 7, v8
    v_lshl_add_u32 v8, v4, 3, v8
    v_lshrrev_b32 v9, 1, v5
    v_and_b32 v12, 1, v1
    v_lshl_add_u32 v9, v12, 1, v9
    v_lshl_add_u32 v8, v9, 5, v8
    v_add_u32 v8, s11, v8
    v_xor_b32 v9, 32, v8
    v_xor_b32 v12, 64, v8
    v_xor_b32 v13, 0x60, v8
    v_mov_b32 v6, 0xff
    s_waitcnt vmcnt(0)
    ds_read_b64_tr_b16 v[64:65], v8 offset:0
    ds_read_b64_tr_b16 v[66:67], v8 offset:512
    ds_read_b64_tr_b16 v[68:69], v9 offset:0
    ds_read_b64_tr_b16 v[70:71], v9 offset:512
    ds_read_b64_tr_b16 v[72:73], v12 offset:0
    ds_read_b64_tr_b16 v[74:75], v12 offset:512
    ds_read_b64_tr_b16 v[76:77], v13 offset:0
    ds_read_b64_tr_b16 v[78:79], v13 offset:512
    ds_read_b64_tr_b16 v[80:81], v8 offset:4096
    ds_read_b64_tr_b16 v[82:83], v8 offset:4608
    ds_read_b64_tr_b16 v[84:85], v9 offset:4096
    ds_read_b64_tr_b16 v[86:87], v9 offset:4608
    ds_read_b64_tr_b16 v[88:89], v12 offset:4096
    ds_read_b64_tr_b16 v[90:91], v12 offset:4608
    ds_read_b64_tr_b16 v[92:93], v13 offset:4096
    ds_read_b64_tr_b16 v[94:95], v13 offset:4608
    ds_read_b64_tr_b16 v[96:97], v8 offset:8192
    ds_read_b64_tr_b16 v[98:99], v8 offset:8704
    ds_read_b64_tr_b16 v[100:101], v9 offset:8192
    ds_read_b64_tr_b16 v[102:103], v9 offset:8704
    ds_read_b64_tr_b16 v[104:105], v12 offset:8192
    ds_read_b64_tr_b16 v[106:107], v12 offset:8704
    ds_read_b64_tr_b16 v[108:109], v13 offset:8192
    ds_read_b64_tr_b16 v[110:111], v13 offset:8704
    ds_read_b64_tr_b16 v[112:113], v8 offset:12288
    ds_read_b64_tr_b16 v[114:115], v8 offset:12800
    ds_read_b64_tr_b16 v[116:117], v9 offset:12288
    ds_read_b64_tr_b16 v[118:119], v9 offset:12800
    ds_read_b64_tr_b16 v[120:121], v12 offset:12288
    ds_read_b64_tr_b16 v[122:123], v12 offset:12800
    ds_read_b64_tr_b16 v[124:125], v13 offset:12288
    ds_read_b64_tr_b16 v[126:127], v13 offset:12800
    s_waitcnt lgkmcnt(0)
    v_mfma_f32_16x16x32_bf16 v[32:35], v[64:67], v[16:19], 0
    v_mfma_f32_16x16x32_bf16 v[36:39], v[68:71], v[16:19], 0
    v_mfma_f32_16x16x32_bf16 v[40:43], v[72:75], v[16:19], 0
    v_mfma_f32_16x16x32_bf16 v[44:47], v[76:79], v[16:19], 0
    v_mfma_f32_16x16x32_bf16 v[32:35], v[80:83], v[20:23], v[32:35]
    v_mfma_f32_16x16x32_bf16 v[36:39], v[84:87], v[20:23], v[36:39]
    v_mfma_f32_16x16x32_bf16 v[40:43], v[88:91], v[20:23], v[40:43]
    v_mfma_f32_16x16x32_bf16 v[44:47], v[92:95], v[20:23], v[44:47]
    v_mfma_f32_16x16x32_bf16 v[32:35], v[96:99], v[24:27], v[32:35]
    v_mfma_f32_16x16x32_bf16 v[36:39], v[100:103], v[24:27], v[36:39]
    v_mfma_f32_16x16x32_bf16 v[40:43], v[104:107], v[24:27], v[40:43]
    v_mfma_f32_16x16x32_bf16 v[44:47], v[108:111], v[24:27], v[44:47]
    v_mfma_f32_16x16x32_bf16 v[32:35], v[112:115], v[28:31], v[32:35]
    v_mfma_f32_16x16x32_bf16 v[36:39], v[116:119], v[28:31], v[36:39]
    v_mfma_f32_16x16x32_bf16 v[40:43], v[120:123], v[28:31], v[40:43]
    v_mfma_f32_16x16x32_bf16 v[44:47], v[124:127], v[28:31], v[44:47]
    s_add_u32 s56, s56, 1
    s_bfe_u32 s27, s56, 0x70008
    s_or_b32 s27, s27, 0x80
    s_xor_b32 s26, s56, s27
    s_and_b32 s27, s26, 0xff
    v_mul_lo_u32 v8, v4, s10
    v_lshl_add_u32 v8, v1, 4, v8
    v_lshl_add_u32 v8, v5, 6, v8
    s_getreg_b32 s12, hwreg(HW_REG_XCC_ID, 0, 4)
    s_lshl_b32 s12, s12, 4
    s_and_b32 s13, s56, 15
    s_or_b32 s12, s12, s13
    s_cmp_eq_u32 s3, 0
    s_cselect_b32 s12, s12, s56
    v_mov_b32_dpp v32, v36 row_shr:4 row_mask:0xf bank_mask:0x2
    v_mov_b32_dpp v33, v37 row_shr:4 row_mask:0xf bank_mask:0x2
    v_mov_b32_dpp v34, v38 row_shr:4 row_mask:0xf bank_mask:0x2
    v_mov_b32_dpp v35, v39 row_shr:4 row_mask:0xf bank_mask:0x2
    v_mov_b32_dpp v32, v40 row_shr:8 row_mask:0xf bank_mask:0x4
    v_mov_b32_dpp v33, v41 row_shr:8 row_mask:0xf bank_mask:0x4
    v_mov_b32_dpp v34, v42 row_shr:8 row_mask:0xf bank_mask:0x4
    v_mov_b32_dpp v35, v43 row_shr:8 row_mask:0xf bank_mask:0x4
    v_mov_b32_dpp v32, v44 row_shr:12 row_mask:0xf bank_mask:0x8
    v_mov_b32_dpp v33, v45 row_shr:12 row_mask:0xf bank_mask:0x8
    v_mov_b32_dpp v34, v46 row_shr:12 row_mask:0xf bank_mask:0x8
    v_mov_b32_dpp v35, v47 row_shr:12 row_mask:0xf bank_mask:0x8
    v_add_u32 v32, 0x80, v32
    v_add_u32 v33, 0x80, v33
    v_add_u32 v34, 0x80, v34
    v_add_u32 v35, 0x80, v35
    v_bfi_b32 v33, v6, s26, v33
    v_bfi_b32 v34, v6, s56, v34
    v_bfi_b32 v35, v6, s26, v35
    v_bfi_b32 v32, v6, s12, v32
    buffer_store_dwordx4 v[32:35], v8, s[52:55], s9 offen
    v_bfe_u32 v8, v0, 1, 3
    v_xor_b32 v8, v8, v1
    v_and_b32 v9, 1, v0
    v_lshlrev_b32 v9, 4, v9
    v_lshl_add_u32 v10, v8, 5, v9
    v_xor_b32 v11, 0x80, v10
    v_lshl_add_u32 v12, v1, 10, v10
    v_lshl_add_u32 v13, v1, 10, v11
    v_lshl_add_u32 v10, v1, 8, v10
    v_lshl_add_u32 v11, v1, 8, v11
    s_cmp_eq_u32 s3, 0
    s_cbranch_scc0 L_a1
    s_lshr_b32 s12, s5, 3
    s_lshl_b32 s12, s12, 3
    s_add_u32 s12, s12, s4
    s_lshl_b32 s12, s12, 22
    s_and_b32 s13, s5, 7
    s_lshl_b32 s13, s13, 17
    s_add_u32 s12, s12, s13
    s_add_u32 s12, s12, 0x300000
    s_add_u32 s44, s20, s12
    s_addc_u32 s45, s21, 0
    s_mov_b32 s46, 0x20000
    s_lshl_b32 s12, s4, 19
    s_lshr_b32 s13, s5, 4
    s_lshl_b32 s13, s13, 18
    s_add_u32 s12, s12, s13
    s_and_b32 s13, s7, 3
    s_lshl_b32 s13, s13, 15
    s_add_u32 s12, s12, s13
    s_lshl_b32 s13, s6, 8
    s_add_u32 s12, s12, s13
    s_add_u32 s48, s24, s12
    s_addc_u32 s49, s25, 0
    s_mov_b32 s50, 163072
    s_lshr_b32 s12, s4, 1
    s_xor_b32 s12, s12, 3
    s_and_b32 s13, s4, 1
    s_lshl_b32 s13, s13, 2
    s_or_b32 s12, s12, s13
    s_and_b32 s13, s5, 24
    s_xor_b32 s13, s13, 16
    s_add_u32 s12, s12, s13
    s_and_b32 s13, s12, 7
    s_cmp_lt_u32 s12, 28
    s_cselect_b32 s12, s12, s13
    s_mov_b32 s54, 32000
    s_lshl_b32 s12, s12, 16
    s_bfe_u32 s13, s5, 0x10002
    s_lshl_b32 s13, s13, 15
    s_add_u32 s12, s12, s13
    s_lshl_b32 s13, s6, 8
    s_add_u32 s12, s12, s13
    s_add_u32 s52, s32, s12
    s_addc_u32 s53, s33, 0
    s_mov_b32 s12, 0
    s_mov_b32 s13, -6
    s_and_b32 s11, s5, 7
    s_lshl_b32 s11, s11, 12
spin_1:
    ds_read_b32 v3, v2 offset:0
    s_sub_u32 s15, s15, 1
    s_cbranch_scc1 L_end
    s_waitcnt lgkmcnt(0)
    v_readfirstlane_b32 s61, v3
    s_cmp_ge_u32 s61, 1
    s_cbranch_scc0 spin_1
spin_2:
    ds_read_b32 v3, v2 offset:20
    s_sub_u32 s15, s15, 1
    s_cbranch_scc1 L_end
    s_waitcnt lgkmcnt(0)
    v_readfirstlane_b32 s61, v3
    s_cmp_ge_u32 s61, 8
    s_cbranch_scc0 spin_2
L_vloop:
    s_xor_b32 s8, s12, s11
    s_mov_b32 m0, s12
    s_xor_b32 s9, s8, 0x1000
    buffer_load_dwordx4 v10, s[44:47], s8 offen nt lds
    buffer_load_dwordx4 v11, s[44:47], s8 offen offset:1024 nt lds
    buffer_load_dwordx4 v10, s[44:47], s8 offen offset:2048 nt lds
    buffer_load_dwordx4 v11, s[44:47], s8 offen offset:3072 nt lds
    s_add_u32 m0, s12, 4096
    s_add_u32 s13, s13, 1
    buffer_load_dwordx4 v10, s[44:47], s9 offen nt lds
    buffer_load_dwordx4 v11, s[44:47], s9 offen offset:1024 nt lds
    buffer_load_dwordx4 v10, s[44:47], s9 offen offset:2048 nt lds
    buffer_load_dwordx4 v11, s[44:47], s9 offen offset:3072 nt lds
    s_max_i32 s14, s13, 0
    v_mov_b32 v9, s14
    s_waitcnt vmcnt(48)
    ds_write_b32 v2, v9 offset:16
    s_add_u32 s12, s12, 8192
    s_cmp_lt_u32 s12, 0x20000
    s_cbranch_scc1 L_vloop
    s_mov_b32 m0, 131072
    s_mov_b32 s12, 0
    buffer_load_dwordx4 v12, s[48:51], s12 offen nt lds
    s_add_u32 m0, m0, 1024
    s_add_u32 s12, s12, 4096
    buffer_load_dwordx4 v13, s[48:51], s12 offen nt lds
    s_add_u32 m0, m0, 1024
    s_add_u32 s12, s12, 4096
    buffer_load_dwordx4 v12, s[48:51], s12 offen nt lds
    s_add_u32 m0, m0, 1024
    s_add_u32 s12, s12, 4096
    buffer_load_dwordx4 v13, s[48:51], s12 offen nt lds
    s_add_u32 m0, m0, 1024
    s_add_u32 s12, s12, 4096
    buffer_load_dwordx4 v12, s[48:51], s12 offen nt lds
    s_add_u32 m0, m0, 1024
    s_add_u32 s12, s12, 4096
    buffer_load_dwordx4 v13, s[48:51], s12 offen nt lds
    s_add_u32 m0, m0, 1024
    s_add_u32 s12, s12, 4096
    buffer_load_dwordx4 v12, s[48:51], s12 offen nt lds
    s_add_u32 m0, m0, 1024
    s_add_u32 s12, s12, 4096
    buffer_load_dwordx4 v13, s[48:51], s12 offen nt lds
    s_add_u32 m0, m0, 1024
    s_add_u32 s12, s12, 102400
    v_mov_b32 v9, 11
    s_waitcnt vmcnt(48)
    ds_write_b32 v2, v9 offset:16
    buffer_load_dwordx4 v12, s[48:51], s12 offen nt lds
    s_add_u32 m0, m0, 1024
    s_add_u32 s12, s12, 4096
    buffer_load_dwordx4 v13, s[48:51], s12 offen nt lds
    s_add_u32 m0, m0, 1024
    s_add_u32 s12, s12, 4096
    buffer_load_dwordx4 v12, s[48:51], s12 offen nt lds
    s_add_u32 m0, m0, 1024
    s_add_u32 s12, s12, 4096
    buffer_load_dwordx4 v13, s[48:51], s12 offen nt lds
    s_add_u32 m0, m0, 1024
    s_add_u32 s12, s12, 4096
    buffer_load_dwordx4 v12, s[48:51], s12 offen nt lds
    s_add_u32 m0, m0, 1024
    s_add_u32 s12, s12, 4096
    buffer_load_dwordx4 v13, s[48:51], s12 offen nt lds
    s_add_u32 m0, m0, 1024
    s_add_u32 s12, s12, 4096
    buffer_load_dwordx4 v12, s[48:51], s12 offen nt lds
    s_add_u32 m0, m0, 1024
    s_add_u32 s12, s12, 4096
    buffer_load_dwordx4 v13, s[48:51], s12 offen nt lds
    s_add_u32 m0, m0, 1024
    s_mov_b32 s12, 0
    v_mov_b32 v9, 12
    s_waitcnt vmcnt(48)
    ds_write_b32 v2, v9 offset:16
    buffer_load_dwordx4 v12, s[52:55], s12 offen nt lds
    s_add_u32 m0, m0, 1024
    s_add_u32 s12, s12, 4096
    buffer_load_dwordx4 v13, s[52:55], s12 offen nt lds
    s_add_u32 m0, m0, 1024
    s_add_u32 s12, s12, 4096
    buffer_load_dwordx4 v12, s[52:55], s12 offen nt lds
    s_add_u32 m0, m0, 1024
    s_add_u32 s12, s12, 4096
    buffer_load_dwordx4 v13, s[52:55], s12 offen nt lds
    s_add_u32 m0, m0, 1024
    s_add_u32 s12, s12, 4096
    buffer_load_dwordx4 v12, s[52:55], s12 offen nt lds
    s_add_u32 m0, m0, 1024
    s_add_u32 s12, s12, 4096
    buffer_load_dwordx4 v13, s[52:55], s12 offen nt lds
    s_add_u32 m0, m0, 1024
    s_add_u32 s12, s12, 4096
    buffer_load_dwordx4 v12, s[52:55], s12 offen nt lds
    s_add_u32 m0, m0, 1024
    s_add_u32 s12, s12, 4096
    buffer_load_dwordx4 v13, s[52:55], s12 offen nt lds
    ds_read_b32 v3, v2 offset:28
    s_waitcnt lgkmcnt(0)
    v_readfirstlane_b32 s61, v3
    s_cmp_eq_u32 s61, 0
    s_cbranch_scc1 nrf_3
    buffer_wbl2 sc1
    s_waitcnt vmcnt(0)
nrf_3:
    v_mov_b32 v9, 13
    s_waitcnt vmcnt(48)
    ds_write_b32 v2, v9 offset:16
    v_mov_b32 v9, 14
    s_waitcnt vmcnt(40)
    ds_write_b32 v2, v9 offset:16
    s_waitcnt vmcnt(32)
    s_barrier
    s_waitcnt vmcnt(24)
    s_barrier
    s_waitcnt vmcnt(0)
    s_barrier
    s_endpgm
L_a1:
    s_mov_b64 exec, 1
    v_mov_b32 v3, 1
    ds_add_u32 v2, v3 offset:0
    s_mov_b64 exec, -1
    s_mov_b32 s44, s34
    s_mov_b32 s45, s35
    s_mov_b32 s46, 4096
    v_mov_b32 v8, 0
    buffer_load_dword v62, v8, s[44:47], 0 offen
    v_mov_b32 v112, 0
    v_mov_b32 v113, 0
    v_mov_b32 v114, 0
    v_mov_b32 v115, 0
    s_cmp_lt_u32 s57, 28
    s_cbranch_scc0 L_hout
    v_lshlrev_b32 v9, 10, v5
    v_lshl_add_u32 v9, v4, 8, v9
    v_lshl_add_u32 v9, v1, 4, v9
    s_lshl_b32 s12, s57, 13
    s_bfe_u32 s13, s5, 0x10002
    s_lshl_b32 s13, s13, 7
    s_add_u32 s12, s12, s13
    s_add_u32 s12, s12, 262144
    s_add_u32 s13, s12, 4096
    s_mov_b32 s14, 0
    s_and_b32 s55, s56, 0xff
L_gupoll:
    buffer_load_dwordx4 v[96:99], v9, s[40:43], s12 offen sc1
    buffer_load_dwordx4 v[100:103], v9, s[40:43], s12 offen offset:64 sc1
    buffer_load_dwordx4 v[104:107], v9, s[40:43], s13 offen sc1
    buffer_load_dwordx4 v[108:111], v9, s[40:43], s13 offen offset:64 sc1
    s_sub_u32 s15, s15, 4
    s_cbranch_scc1 L_end
    s_waitcnt vmcnt(0)
    v_xor_b32 v96, s55, v96
    v_xor_b32 v97, s27, v97
    v_xor_b32 v98, s55, v98
    v_xor_b32 v99, s27, v99
    v_xor_b32 v100, s55, v100
    v_xor_b32 v101, s27, v101
    v_xor_b32 v102, s55, v102
    v_xor_b32 v103, s27, v103
    v_xor_b32 v104, s55, v104
    v_xor_b32 v105, s27, v105
    v_xor_b32 v106, s55, v106
    v_xor_b32 v107, s27, v107
    v_xor_b32 v108, s55, v108
    v_xor_b32 v109, s27, v109
    v_xor_b32 v110, s55, v110
    v_xor_b32 v111, s27, v111
    v_or3_b32 v3, v96, v97, v98
    v_or3_b32 v3, v3, v99, v100
    v_or3_b32 v3, v3, v101, v102
    v_or3_b32 v3, v3, v103, v104
    v_or3_b32 v3, v3, v105, v106
    v_or3_b32 v3, v3, v107, v108
    v_or3_b32 v3, v3, v109, v110
    v_or_b32 v3, v3, v111
    v_and_b32 v3, 0xff, v3
    v_cmp_ne_u32 vcc, 0, v3
    s_cbranch_vccz L_guok
    s_add_u32 s14, s14, 1
    s_cmp_ge_u32 s14, 24
    s_cbranch_scc1 rem_4
rem_4_back:
    s_sleep 4
    s_branch L_gupoll
L_guok:
    ds_read_b32 v3, v2 offset:28
    s_waitcnt lgkmcnt(0)
    v_readfirstlane_b32 s61, v3
    s_cmp_eq_u32 s61, 0
    s_cbranch_scc1 nrf_5
    buffer_wbl2 sc1
    s_waitcnt vmcnt(0)
nrf_5:
    v_add_f32_dpp v96, v96, v96 row_ror:4 row_mask:0xf bank_mask:0xf
    v_add_f32_dpp v97, v97, v97 row_ror:4 row_mask:0xf bank_mask:0xf
    v_add_f32_dpp v98, v98, v98 row_ror:4 row_mask:0xf bank_mask:0xf
    v_add_f32_dpp v99, v99, v99 row_ror:4 row_mask:0xf bank_mask:0xf
    v_add_f32_dpp v100, v100, v100 row_ror:4 row_mask:0xf bank_mask:0xf
    v_add_f32_dpp v101, v101, v101 row_ror:4 row_mask:0xf bank_mask:0xf
    v_add_f32_dpp v102, v102, v102 row_ror:4 row_mask:0xf bank_mask:0xf
    v_add_f32_dpp v103, v103, v103 row_ror:4 row_mask:0xf bank_mask:0xf
    v_add_f32_dpp v104, v104, v104 row_ror:4 row_mask:0xf bank_mask:0xf
    v_add_f32_dpp v105, v105, v105 row_ror:4 row_mask:0xf bank_mask:0xf
    v_add_f32_dpp v106, v106, v106 row_ror:4 row_mask:0xf bank_mask:0xf
    v_add_f32_dpp v107, v107, v107 row_ror:4 row_mask:0xf bank_mask:0xf
    v_add_f32_dpp v108, v108, v108 row_ror:4 row_mask:0xf bank_mask:0xf
    v_add_f32_dpp v109, v109, v109 row_ror:4 row_mask:0xf bank_mask:0xf
    v_add_f32_dpp v110, v110, v110 row_ror:4 row_mask:0xf bank_mask:0xf
    v_add_f32_dpp v111, v111, v111 row_ror:4 row_mask:0xf bank_mask:0xf
    v_add_f32_dpp v96, v96, v96 row_ror:8 row_mask:0xf bank_mask:0xf
    v_add_f32_dpp v97, v97, v97 row_ror:8 row_mask:0xf bank_mask:0xf
    v_add_f32_dpp v98, v98, v98 row_ror:8 row_mask:0xf bank_mask:0xf
    v_add_f32_dpp v99, v99, v99 row_ror:8 row_mask:0xf bank_mask:0xf
    v_add_f32_dpp v100, v100, v100 row_ror:8 row_mask:0xf bank_mask:0xf
    v_add_f32_dpp v101, v101, v101 row_ror:8 row_mask:0xf bank_mask:0xf
    v_add_f32_dpp v102, v102, v102 row_ror:8 row_mask:0xf bank_mask:0xf
    v_add_f32_dpp v103, v103, v103 row_ror:8 row_mask:0xf bank_mask:0xf
    v_add_f32_dpp v104, v104, v104 row_ror:8 row_mask:0xf bank_mask:0xf
    v_add_f32_dpp v105, v105, v105 row_ror:8 row_mask:0xf bank_mask:0xf
    v_add_f32_dpp v106, v106, v106 row_ror:8 row_mask:0xf bank_mask:0xf
    v_add_f32_dpp v107, v107, v107 row_ror:8 row_mask:0xf bank_mask:0xf
    v_add_f32_dpp v108, v108, v108 row_ror:8 row_mask:0xf bank_mask:0xf
    v_add_f32_dpp v109, v109, v109 row_ror:8 row_mask:0xf bank_mask:0xf
    v_add_f32_dpp v110, v110, v110 row_ror:8 row_mask:0xf bank_mask:0xf
    v_add_f32_dpp v111, v111, v111 row_ror:8 row_mask:0xf bank_mask:0xf
    v_cvt_pk_bf16_f32 v112, v96, v97
    v_cvt_pk_bf16_f32 v113, v98, v99
    v_cvt_pk_bf16_f32 v114, v100, v101
    v_cvt_pk_bf16_f32 v115, v102, v103
    v_cvt_pk_bf16_f32 v116, v104, v105
    v_cvt_pk_bf16_f32 v117, v106, v107
    v_cvt_pk_bf16_f32 v118, v108, v109
    v_cvt_pk_bf16_f32 v119, v110, v111
    v_lshlrev_b32 v96, 16, v112
    v_and_b32 v97, 0xffff0000, v112
    v_lshlrev_b32 v98, 16, v113
    v_and_b32 v99, 0xffff0000, v113
    v_lshlrev_b32 v100, 16, v114
    v_and_b32 v101, 0xffff0000, v114
    v_lshlrev_b32 v102, 16, v115
    v_and_b32 v103, 0xffff0000, v115
    v_lshlrev_b32 v104, 16, v116
    v_and_b32 v105, 0xffff0000, v116
    v_lshlrev_b32 v106, 16, v117
    v_and_b32 v107, 0xffff0000, v117
    v_lshlrev_b32 v108, 16, v118
    v_and_b32 v109, 0xffff0000, v118
    v_lshlrev_b32 v110, 16, v119
    v_and_b32 v111, 0xffff0000, v119
    v_mul_f32 v112, 0xbfb8aa3b, v96
    v_mul_f32 v113, 0xbfb8aa3b, v97
    v_mul_f32 v114, 0xbfb8aa3b, v98
    v_mul_f32 v115, 0xbfb8aa3b, v99
    v_mul_f32 v116, 0xbfb8aa3b, v100
    v_mul_f32 v117, 0xbfb8aa3b, v101
    v_mul_f32 v118, 0xbfb8aa3b, v102
    v_mul_f32 v119, 0xbfb8aa3b, v103
    v_exp_f32 v112, v112
    v_exp_f32 v113, v113
    v_exp_f32 v114, v114
    v_exp_f32 v115, v115
    v_exp_f32 v116, v116
    v_exp_f32 v117, v117
    v_exp_f32 v118, v118
    v_exp_f32 v119, v119
    v_add_f32 v112, 1.0, v112
    v_add_f32 v113, 1.0, v113
    v_add_f32 v114, 1.0, v114
    v_add_f32 v115, 1.0, v115
    v_add_f32 v116, 1.0, v116
    v_add_f32 v117, 1.0, v117
    v_add_f32 v118, 1.0, v118
    v_add_f32 v119, 1.0, v119
    v_rcp_f32 v112, v112
    v_rcp_f32 v113, v113
    v_rcp_f32 v114, v114
    v_rcp_f32 v115, v115
    v_rcp_f32 v116, v116
    v_rcp_f32 v117, v117
    v_rcp_f32 v118, v118
    v_rcp_f32 v119, v119
    v_mul_f32 v96, v96, v112
    v_mul_f32 v97, v97, v113
    v_mul_f32 v98, v98, v114
    v_mul_f32 v99, v99, v115
    v_mul_f32 v100, v100, v116
    v_mul_f32 v101, v101, v117
    v_mul_f32 v102, v102, v118
    v_mul_f32 v103, v103, v119
    v_cvt_pk_bf16_f32 v112, v96, v97
    v_cvt_pk_bf16_f32 v113, v98, v99
    v_cvt_pk_bf16_f32 v114, v100, v101
    v_cvt_pk_bf16_f32 v115, v102, v103
    v_lshlrev_b32 v96, 16, v112
    v_and_b32 v97, 0xffff0000, v112
    v_lshlrev_b32 v98, 16, v113
    v_and_b32 v99, 0xffff0000, v113
    v_lshlrev_b32 v100, 16, v114
    v_and_b32 v101, 0xffff0000, v114
    v_lshlrev_b32 v102, 16, v115
    v_and_b32 v103, 0xffff0000, v115
    v_mul_f32 v96, v96, v104
    v_mul_f32 v97, v97, v105
    v_mul_f32 v98, v98, v106
    v_mul_f32 v99, v99, v107
    v_mul_f32 v100, v100, v108
    v_mul_f32 v101, v101, v109
    v_mul_f32 v102, v102, v110
    v_mul_f32 v103, v103, v111
    v_cvt_pk_bf16_f32 v112, v96, v97
    v_cvt_pk_bf16_f32 v113, v98, v99
    v_cvt_pk_bf16_f32 v114, v100, v101
    v_cvt_pk_bf16_f32 v115, v102, v103
L_hout:
    v_lshlrev_b32 v8, 6, v4
    v_lshl_add_u32 v8, v1, 4, v8
    v_add_u32 v8, v8, v2
    ds_write_b128 v8, v[112:115] offset:128
    s_waitcnt lgkmcnt(0)
    s_endpgm
L_main:
    s_cmp_ge_u32 s2, 256
    s_cbranch_scc1 L_end
    v_lshrrev_b32 v1, 6, v0
    v_and_b32 v0, 63, v0
    v_mov_b32 v2, 160768
    v_readfirstlane_b32 s3, v1
    v_lshrrev_b32 v1, 4, v0
    s_mov_b32 s15, 0x200000
    s_mov_b32 s42, 2162688
    s_mov_b32 s43, 0x20000
    s_mov_b32 s47, 0x20000
    s_mov_b32 s51, 0x20000
    s_setprio 1
    s_load_dword s56, s[38:39], 520192
    s_lshr_b32 s11, s5, 3
    v_and_b32 v4, 15, v0
    s_mov_b32 s40, s38
    s_mov_b32 s41, s39
    v_xor_b32 v6, 0x1000, v5
    v_xor_b32 v7, 0x2000, v5
    v_xor_b32 v8, 0x3000, v5
    s_barrier
    global_load_dwordx4 v[80:83], v6, s[18:19] offset:0 nt
    global_load_dwordx4 v[84:87], v6, s[18:19] offset:128 nt
    global_load_dwordx4 v[88:91], v6, s[18:19] offset:2048 nt
    global_load_dwordx4 v[92:95], v6, s[18:19] offset:2176 nt
    global_load_dwordx4 v[96:99], v7, s[18:19] offset:0 nt
    global_load_dwordx4 v[100:103], v7, s[18:19] offset:128 nt
    global_load_dwordx4 v[104:107], v7, s[18:19] offset:2048 nt
    global_load_dwordx4 v[108:111], v7, s[18:19] offset:2176 nt
    global_load_dwordx4 v[112:115], v8, s[18:19] offset:0 nt
    global_load_dwordx4 v[116:119], v8, s[18:19] offset:128 nt
    global_load_dwordx4 v[120:123], v8, s[18:19] offset:2048 nt
    global_load_dwordx4 v[124:127], v8, s[18:19] offset:2176 nt
    s_mov_b64 exec, 1
    v_mov_b32 v3, 1
    ds_add_u32 v2, v3 offset:20
    s_mov_b64 exec, -1
    v_lshlrev_b32 v17, 11, v1
    v_lshl_add_u32 v17, v4, 4, v17
    s_lshl_b32 s12, s4, 2
    s_add_u32 s12, s12, s11
    s_lshl_b32 s12, s12, 13
    s_lshl_b32 s10, s3, 8
    s_add_u32 s12, s12, s10
    s_add_u32 s12, s12, 0
    buffer_load_dwordx4 v[24:27], v17, s[40:43], s12 offen sc1
    v_and_b32 v6, 3, v0
    v_bfe_u32 v7, v0, 2, 2
    v_lshlrev_b32 v8, 8, v6
    v_lshl_add_u32 v8, v1, 5, v8
    v_and_b32 v12, 1, v7
    v_lshl_add_u32 v8, v12, 4, v8
    v_add_u32 v8, 159744, v8
    v_lshl_add_u32 v9, v6, 2, v2
    v_lshlrev_b32 v10, 6, v1
    v_lshl_add_u32 v10, v6, 4, v10
    v_add_u32 v10, 155648, v10
    s_lshl_b32 s13, s3, 9
    s_add_u32 s13, s13, 155648
    v_lshlrev_b32 v11, 8, v12
    v_lshl_add_u32 v11, v6, 4, v11
    v_lshrrev_b32 v12, 1, v7
    v_lshl_add_u32 v11, v12, 7, v11
    v_and_b32 v12, 1, v1
    v_lshl_add_u32 v11, v12, 6, v11
    v_lshrrev_b32 v12, 1, v1
    v_lshl_add_u32 v11, v12, 3, v11
    v_add_u32 v11, s13, v11
    v_lshlrev_b32 v12, 2, v1
    v_add_u32 v12, v12, v7
    v_and_b32 v13, 7, v12
    v_xor_b32 v13, s3, v13
    v_lshlrev_b32 v12, 8, v12
    v_lshl_add_u32 v12, v13, 5, v12
    v_lshl_add_u32 v12, v6, 3, v12
    v_add_u32 v13, 131072, v12
    s_mov_b32 s62, 0x000f000f
    s_mov_b32 s63, 0x000f000f
    v_mov_b32 v23, 0xff
    s_lshl_b32 s13, s3, 7
    s_add_u32 s13, s13, 159744
    v_lshlrev_b32 v14, 3, v4
    v_add_u32 v14, s13, v14
    s_mov_b32 s30, 0x00ff00ff
    s_mov_b32 s31, 0x00ff00ff
    v_mov_b32 v48, 0
    v_mov_b32 v49, 0
    v_mov_b32 v50, 0
    v_mov_b32 v51, 0
    v_mov_b32 v52, 0
    v_mov_b32 v53, 0
    v_mov_b32 v54, 0
    v_mov_b32 v55, 0
    v_mov_b32 v56, 0
    v_mov_b32 v57, 0
    v_mov_b32 v58, 0
    v_mov_b32 v59, 0
    v_mov_b32 v60, 0
    v_mov_b32 v61, 0
    v_mov_b32 v62, 0
    v_mov_b32 v63, 0
    s_waitcnt lgkmcnt(0)
    s_add_u32 s56, s56, 1
    s_bfe_u32 s27, s56, 0x70008
    s_or_b32 s27, s27, 0x80
    s_xor_b32 s26, s56, s27
    s_and_b32 s27, s26, 0xff
    s_mov_b32 s14, 0
L_qpoll:
    s_waitcnt vmcnt(0)
    v_xor_b32 v3, s56, v24
    v_and_b32 v3, 15, v3
    v_bitop3_b32 v3, v25, s26, v3 bitop3:0xbe
    v_bitop3_b32 v3, v26, s56, v3 bitop3:0xbe
    v_bitop3_b32 v3, v27, s26, v3 bitop3:0xbe
    v_and_b32 v3, 0xff, v3
    v_cmp_ne_u32 vcc, 0, v3
    s_cbranch_vccz L_qok
    s_add_u32 s14, s14, 1
    s_cmp_ge_u32 s14, 24
    s_cbranch_scc1 rem_6
rem_6_back:
    s_sub_u32 s15, s15, 4
    s_cbranch_scc1 L_end
    s_sleep 4
    buffer_load_dwordx4 v[24:27], v17, s[40:43], s12 offen sc1
    s_branch L_qpoll
L_qok:
    s_getreg_b32 s13, hwreg(HW_REG_XCC_ID, 0, 4)
    v_bfe_u32 v3, v24, 4, 4
    v_cmp_ne_u32 vcc, s13, v3
    s_cbranch_vccnz rem_7
rem_7_back:
    v_and_b32 v24, 0xffffff00, v24
    v_and_b32 v25, 0xffffff00, v25
    v_and_b32 v26, 0xffffff00, v26
    v_and_b32 v27, 0xffffff00, v27
    v_mov_b32 v28, v24
    v_mov_b32 v29, v25
    v_mov_b32 v30, v26
    v_mov_b32 v31, v27
    v_permlane16_swap_b32 v28, v24
    v_permlane16_swap_b32 v29, v25
    v_permlane16_swap_b32 v30, v26
    v_permlane16_swap_b32 v31, v27
    v_add_f32 v24, v24, v28
    v_add_f32 v25, v25, v29
    v_add_f32 v26, v26, v30
    v_add_f32 v27, v27, v31
    v_mov_b32 v28, v24
    v_mov_b32 v29, v25
    v_mov_b32 v30, v26
    v_mov_b32 v31, v27
    v_permlane32_swap_b32 v28, v24
    v_permlane32_swap_b32 v29, v25
    v_permlane32_swap_b32 v30, v26
    v_permlane32_swap_b32 v31, v27
    v_add_f32 v24, v24, v28
    v_add_f32 v25, v25, v29
    v_add_f32 v26, v26, v30
    v_add_f32 v27, v27, v31
    v_cvt_pk_bf16_f32 v24, v24, v25
    v_cvt_pk_bf16_f32 v25, v26, v27
    s_mov_b64 exec, 0xffff
    ds_write_b64 v14, v[24:25]
    s_mov_b64 exec, 1
    v_mov_b32 v3, 1
    ds_add_u32 v2, v3 offset:4
    s_mov_b64 exec, -1
spin_8:
    ds_read_b32 v3, v2 offset:4
    s_sub_u32 s15, s15, 1
    s_cbranch_scc1 L_end
    s_waitcnt lgkmcnt(0)
    v_readfirstlane_b32 s61, v3
    s_cmp_ge_u32 s61, 8
    s_cbranch_scc0 spin_8
    s_mov_b64 exec, s[30:31]
    ds_read_b128 v[48:51], v8
    ds_read_b128 v[52:55], v8 offset:128
    s_not_b64 exec, exec
    ds_read_b128 v[56:59], v8
    ds_read_b128 v[60:63], v8 offset:128
    s_mov_b64 exec, -1
    ds_read_b32 v3, v2 offset:28
    s_waitcnt lgkmcnt(0)
    v_readfirstlane_b32 s57, v3
    v_mfma_f32_16x16x32_bf16 v[32:35], v[64:67], v[48:51], 0
    v_mfma_f32_16x16x32_bf16 v[36:39], v[80:83], v[48:51], 0
    v_mfma_f32_16x16x32_bf16 v[40:43], v[96:99], v[48:51], 0
    v_mfma_f32_16x16x32_bf16 v[44:47], v[112:115], v[48:51], 0
    v_mfma_f32_16x16x32_bf16 v[32:35], v[68:71], v[52:55], v[32:35]
    v_mfma_f32_16x16x32_bf16 v[36:39], v[84:87], v[52:55], v[36:39]
    v_mfma_f32_16x16x32_bf16 v[40:43], v[100:103], v[52:55], v[40:43]
    v_mfma_f32_16x16x32_bf16 v[44:47], v[116:119], v[52:55], v[44:47]
    v_mfma_f32_16x16x32_bf16 v[32:35], v[72:75], v[56:59], v[32:35]
    v_mfma_f32_16x16x32_bf16 v[36:39], v[88:91], v[56:59], v[36:39]
    v_mfma_f32_16x16x32_bf16 v[40:43], v[104:107], v[56:59], v[40:43]
    v_mfma_f32_16x16x32_bf16 v[44:47], v[120:123], v[56:59], v[44:47]
    v_mfma_f32_16x16x32_bf16 v[32:35], v[76:79], v[60:63], v[32:35]
    v_mfma_f32_16x16x32_bf16 v[36:39], v[92:95], v[60:63], v[36:39]
    v_mfma_f32_16x16x32_bf16 v[40:43], v[108:111], v[60:63], v[40:43]
    v_mfma_f32_16x16x32_bf16 v[44:47], v[124:127], v[60:63], v[44:47]
    s_mov_b32 s6, 0x3db504f3
    s_mov_b32 s7, 0x3db504f3
    s_mov_b32 s8, 0x3fb8aa3b
    s_mov_b32 s9, 0x3fb8aa3b
    s_nop 3
    v_permlane32_swap_b32 v32, v36
    v_permlane32_swap_b32 v33, v37
    v_permlane32_swap_b32 v34, v38
    v_permlane32_swap_b32 v35, v39
    v_permlane32_swap_b32 v40, v44
    v_permlane32_swap_b32 v41, v45
    v_permlane32_swap_b32 v42, v46
    v_permlane32_swap_b32 v43, v47
    v_add_f32_dpp v32, v36, v32 row_shl:4 row_mask:0xf bank_mask:0x5
    v_add_f32_dpp v33, v37, v33 row_shl:4 row_mask:0xf bank_mask:0x5
    v_add_f32_dpp v34, v38, v34 row_shl:4 row_mask:0xf bank_mask:0x5
    v_add_f32_dpp v35, v39, v35 row_shl:4 row_mask:0xf bank_mask:0x5
    v_add_f32_dpp v32, v40, v44 row_shr:4 row_mask:0xf bank_mask:0xa
    v_add_f32_dpp v33, v41, v45 row_shr:4 row_mask:0xf bank_mask:0xa
    v_add_f32_dpp v34, v42, v46 row_shr:4 row_mask:0xf bank_mask:0xa
    v_add_f32_dpp v35, v43, v47 row_shr:4 row_mask:0xf bank_mask:0xa
    v_cvt_pk_bf16_f32 v36, v32, v33
    v_cvt_pk_bf16_f32 v37, v34, v35
    v_lshlrev_b32 v32, 16, v36
    v_and_b32 v33, 0xffff0000, v36
    v_lshlrev_b32 v34, 16, v37
    v_and_b32 v35, 0xffff0000, v37
    v_pk_mul_f32 v[32:33], v[32:33], s[6:7]
    v_pk_mul_f32 v[34:35], v[34:35], s[6:7]
    v_cvt_pk_bf16_f32 v36, v32, v33
    v_cvt_pk_bf16_f32 v37, v34, v35
    v_lshlrev_b32 v32, 16, v36
    v_and_b32 v33, 0xffff0000, v36
    v_lshlrev_b32 v34, 16, v37
    v_and_b32 v35, 0xffff0000, v37
    v_pk_mul_f32 v[32:33], v[32:33], s[8:9]
    v_pk_mul_f32 v[34:35], v[34:35], s[8:9]
    v_max3_f32 v14, v32, v33, v34
    v_max_f32 v14, v14, v35
    s_nop 1
    v_max_f32_dpp v14, v14, v14 row_ror:4 row_mask:0xf bank_mask:0xf
    s_nop 1
    v_max_f32_dpp v14, v14, v14 row_ror:8 row_mask:0xf bank_mask:0xf
    v_mov_b32 v15, v14
    s_nop 1
    v_permlane16_swap_b32 v15, v14
    v_max_f32 v14, v14, v15
    v_mov_b32 v15, v14
    s_nop 1
    v_permlane32_swap_b32 v15, v14
    v_max_f32 v14, v14, v15
    s_mov_b64 exec, 15
    ds_max_f32 v9, v14 offset:32
    s_mov_b64 exec, 1
    v_mov_b32 v3, 1
    ds_add_u32 v2, v3 offset:8
    s_mov_b64 exec, -1
spin_9:
    ds_read_b32 v3, v2 offset:8
    s_sub_u32 s15, s15, 1
    s_cbranch_scc1 L_end
    s_waitcnt lgkmcnt(0)
    v_readfirstlane_b32 s61, v3
    s_cmp_ge_u32 s61, 8
    s_cbranch_scc0 spin_9
    ds_read_b32 v24, v9 offset:32
    s_waitcnt lgkmcnt(0)
    v_sub_f32 v32, v32, v24
    v_sub_f32 v33, v33, v24
    v_sub_f32 v34, v34, v24
    v_sub_f32 v35, v35, v24
    v_exp_f32 v32, v32
    v_exp_f32 v33, v33
    v_exp_f32 v34, v34
    v_exp_f32 v35, v35
    v_cvt_pk_bf16_f32 v36, v32, v33
    v_add_f32 v15, v32, v33
    v_cvt_pk_bf16_f32 v37, v34, v35
    v_add_f32 v14, v34, v35
    ds_write_b64 v11, v[36:37]
    v_add_f32 v15, v15, v14
    s_nop 1
    v_add_f32_dpp v15, v15, v15 row_ror:4 row_mask:0xf bank_mask:0xf
    s_nop 1
    v_add_f32_dpp v15, v15, v15 row_ror:8 row_mask:0xf bank_mask:0xf
    v_mov_b32 v32, v15
    s_nop 1
    v_permlane16_swap_b32 v32, v15
    v_add_f32 v15, v15, v32
    v_mov_b32 v32, v15
    s_nop 1
    v_permlane32_swap_b32 v32, v15
    v_add_f32 v15, v15, v32
    v_lshl_add_u32 v14, v6, 5, v2
    s_lshl_b32 s13, s3, 2
    v_add_u32 v32, s13, v14
    s_mov_b64 exec, 15
    ds_write_b32 v32, v15 offset:1024
    s_mov_b64 exec, 1
    v_mov_b32 v3, 1
    ds_add_u32 v2, v3 offset:12
    s_mov_b64 exec, -1
spin_10:
    ds_read_b32 v3, v2 offset:12
    s_sub_u32 s15, s15, 1
    s_cbranch_scc1 L_end
    s_waitcnt lgkmcnt(0)
    v_readfirstlane_b32 s61, v3
    s_cmp_ge_u32 s61, 8
    s_cbranch_scc0 spin_10
    s_lshl_b32 s10, s4, 5
    s_add_u32 s10, s10, s5
    s_cmp_eq_u32 s3, 0
    s_cbranch_scc0 L_noml
    ds_read_b128 v[32:35], v14 offset:1024
    ds_read_b128 v[36:39], v14 offset:1040
    v_lshlrev_b32 v16, 4, v0
    v_mov_b32 v25, s56
    v_mov_b32 v27, s26
    s_lshl_b32 s11, s10, 7
    s_add_u32 s11, s11, 2097152
    s_waitcnt lgkmcnt(0)
    v_pk_add_f32 v[32:33], v[32:33], v[34:35]
    v_pk_add_f32 v[36:37], v[36:37], v[38:39]
    s_nop 0
    v_pk_add_f32 v[32:33], v[32:33], v[36:37]
    s_nop 0
    v_add_f32 v26, v32, v33
    s_mov_b64 exec, 0xff
    buffer_store_dwordx4 v[24:27], v16, s[40:43], s11 offen
    s_cmp_eq_u32 s57, 0
    s_cbranch_scc1 L_mlloc
    buffer_store_dwordx4 v[24:27], v16, s[40:43], s11 offen sc1
L_mlloc:
    s_mov_b64 exec, -1
L_noml:
    s_lshr_b32 s59, s2, 6
    s_bfe_u32 s13, s2, 0x20004
    s_lshl_b32 s58, s13, 9
    s_lshl_b32 s9, s13, 7
    s_lshl_b32 s13, s4, 4
    s_add_u32 s58, s58, s13
    s_lshl_b32 s13, s4, 9
    s_add_u32 s9, s9, s13
    s_and_b32 s13, s2, 8
    s_add_u32 s58, s58, s13
    s_lshl_b32 s13, s13, 3
    s_add_u32 s9, s9, s13
    s_lshl_b32 s13, s59, 7
    s_add_u32 s58, s58, s13
    s_lshl_b32 s58, s58, 1
    v_lshlrev_b32 v16, 6, v6
    v_lshl_add_u32 v16, v1, 4, v16
    s_lshl_b32 s10, s10, 11
    s_lshl_b32 s11, s3, 8
    s_add_u32 s10, s10, s11
    s_add_u32 s10, s10, 524288
    v_and_b32 v14, 7, v0
    v_lshlrev_b32 v17, 11, v1
    v_lshl_add_u32 v17, v14, 4, v17
    v_bfe_u32 v21, v0, 3, 1
    v_lshl_add_u32 v17, v21, 8, v17
    s_lshl_b32 s12, s4, 5
    s_lshl_b32 s13, s3, 2
    s_add_u32 s12, s12, s13
    s_lshl_b32 s12, s12, 11
    s_bfe_u32 s13, s5, 0x20002
    s_lshl_b32 s13, s13, 9
    s_add_u32 s12, s12, s13
    s_lshr_b32 s13, s5, 4
    s_lshl_b32 s13, s13, 7
    s_add_u32 s12, s12, s13
    s_add_u32 s12, s12, 524288
    s_lshr_b32 s13, s5, 2
    s_lshl_b32 s14, s4, 3
    s_add_u32 s13, s13, s14
    s_and_b32 s14, s5, 3
    s_lshl_b32 s14, s14, 6
    s_add_u32 s13, s13, s14
    s_lshl_b32 s13, s13, 11
    s_add_u32 s13, s13, s11
    s_lshl_b32 s13, s13, 1
    s_add_u32 s13, s13, 1048576
    v_lshlrev_b32 v18, 3, v0
    v_and_b32 v22, 1, v7
    v_lshlrev_b32 v19, 7, v14
    v_lshl_add_u32 v19, v21, 4, v19
    s_lshl_b32 s52, s4, 12
    s_lshr_b32 s14, s3, 1
    s_lshl_b32 s14, s14, 10
    s_add_u32 s52, s52, s14
    s_lshr_b32 s14, s5, 4
    s_lshl_b32 s14, s14, 5
    s_add_u32 s52, s52, s14
    s_add_u32 s52, s52, 2097152
    s_and_b32 s14, s3, 1
    s_lshl_b32 s14, s14, 4
    v_lshlrev_b32 v63, 5, v22
    v_lshl_add_u32 v63, v1, 2, v63
    v_add_u32 v63, s14, v63
    v_and_b32 v20, 1, v1
    v_lshlrev_b32 v20, 11, v20
    v_lshl_add_u32 v20, v22, 10, v20
    v_lshl_add_u32 v20, v6, 8, v20
    v_lshl_add_u32 v20, v21, 3, v20
    v_lshrrev_b32 v21, 1, v1
    s_lshl_b32 s14, s3, 1
    v_add_u32 v21, s14, v21
    v_xor_b32 v21, v21, v14
    v_lshl_add_u32 v20, v21, 4, v20
    v_add_u32 v20, 155648, v20
    v_xor_b32 v21, v0, v1
    v_lshlrev_b32 v21, 4, v21
    v_add_u32 v21, 155648, v21
    v_xor_b32 v60, 64, v21
    v_lshrrev_b32 v8, 3, v0
    v_lshlrev_b32 v8, 12, v8
    v_lshl_add_u32 v8, v14, 3, v8
    s_lshl_b32 s8, s59, 18
    s_lshl_b32 s14, s3, 15
    s_add_u32 s8, s8, s14
    s_add_u32 s8, s8, s9
    s_add_u32 s8, s8, 1048576
    v_lshlrev_b32 v9, 6, v7
    v_lshl_add_u32 v9, v1, 4, v9
    v_add_u32 v9, v9, v2
    v_mul_u32_u24 v15, 80, v14
    v_add_u32 v15, v15, v2
    s_lshl_b32 s14, s3, 3
    v_add_u32 v62, s14, v15
    v_lshrrev_b32 v61, 5, v0
    v_lshl_add_u32 v62, v61, 2, v62
    s_mov_b32 s44, s34
    s_mov_b32 s45, s35
    s_mov_b32 s46, 4096
    s_mov_b32 s48, s16
    s_mov_b32 s49, s17
    s_mov_b32 s50, 4096
    v_lshlrev_b32 v11, 1, v14
    v_mov_b32 v5, 520192
    v_mov_b32 v4, s56
    s_mov_b32 s14, 0
    s_mov_b32 s6, 0
    s_mov_b32 s7, 0
    s_mov_b32 s11, 8
    s_mov_b32 s53, 0
    s_and_b32 s55, s56, 0xff
    s_mov_b32 s30, 0xff
    s_mov_b32 s31, 0xff
    v_mov_b32 v48, 0
    v_mov_b32 v49, 0
    v_mov_b32 v50, 0
    v_mov_b32 v51, 0
L_pv:
    ds_read_b128 v[56:59], v10
    s_cmp_gt_u32 s7, s6
    s_cbranch_scc1 L_pv_go
spin_11:
    ds_read_b32 v3, v2 offset:16
    s_sub_u32 s15, s15, 1
    s_cbranch_scc1 L_end
    s_waitcnt lgkmcnt(0)
    v_readfirstlane_b32 s7, v3
    s_cmp_gt_u32 s7, s6
    s_cbranch_scc0 spin_11
L_pv_go:
    ds_read_b64_tr_b16 v[52:53], v12
    ds_read_b64_tr_b16 v[54:55], v12 offset:4096
    v_add_u32 v12, 8192, v12
    v_add_u32 v10, 256, v10
    s_add_u32 s6, s6, 1
    s_cmp_lt_u32 s6, s11
    s_waitcnt lgkmcnt(0)
    v_mfma_f32_16x16x32_bf16 v[48:51], v[52:55], v[56:59], v[48:51]
    s_cbranch_scc1 L_pv
    s_cmp_eq_u32 s6, 14
    s_cbranch_scc1 L_tail
    buffer_load_dwordx4 v[44:47], v19, s[40:43], s52 offen sc1
    buffer_load_ushort v31, v11, s[48:51], s58 offen
    s_mov_b32 s11, 14
    s_branch L_pv
L_tail:
    ds_read_b128 v[64:67], v10 offset:0
    ds_read_b128 v[68:71], v10 offset:256
    s_waitcnt lgkmcnt(0)
    s_barrier
    ds_read_b64_tr_b16 v[96:97], v12 offset:0
    ds_read_b64_tr_b16 v[98:99], v12 offset:4096
    s_barrier
    ds_read_b64_tr_b16 v[100:101], v12 offset:8192
    ds_read_b64_tr_b16 v[102:103], v12 offset:12288
    s_waitcnt lgkmcnt(2)
    v_mfma_f32_16x16x32_bf16 v[48:51], v[96:99], v[64:67], v[48:51]
    s_waitcnt lgkmcnt(0)
    v_mfma_f32_16x16x32_bf16 v[48:51], v[100:103], v[68:71], v[48:51]
    s_mov_b64 exec, s[62:63]
    s_nop 6
    v_bfi_b32 v48, v23, s56, v48
    v_bfi_b32 v49, v23, s26, v49
    v_bfi_b32 v50, v23, s56, v50
    v_bfi_b32 v51, v23, s26, v51
    buffer_store_dwordx4 v[48:51], v16, s[40:43], s10 offen
    s_cmp_eq_u32 s57, 0
    s_cbranch_scc0 L_orem
L_oloc:
    s_mov_b64 exec, -1
    s_waitcnt vmcnt(1)
L_mlpoll:
    v_xor_b32 v3, s56, v45
    v_bitop3_b32 v3, v47, s26, v3 bitop3:0xbe
    v_cmp_ne_u32 vcc, 0, v3
    s_cbranch_vccnz L_mlretry
L_mlok:
    v_max_f32_dpp v45, v44, v44 quad_perm:[1,0,3,2] row_mask:0xf bank_mask:0xf
    s_nop 1
    v_max_f32_dpp v45, v45, v45 quad_perm:[2,3,0,1] row_mask:0xf bank_mask:0xf
    s_nop 1
    v_max_f32_dpp v45, v45, v45 row_half_mirror row_mask:0xf bank_mask:0xf
    v_sub_f32 v44, v44, v45
    v_exp_f32 v44, v44
    s_nop 0
    v_mul_f32 v46, v46, v44
    s_nop 1
    v_add_f32_dpp v46, v46, v46 quad_perm:[1,0,3,2] row_mask:0xf bank_mask:0xf
    s_nop 1
    v_add_f32_dpp v46, v46, v46 quad_perm:[2,3,0,1] row_mask:0xf bank_mask:0xf
    s_nop 1
    v_add_f32_dpp v46, v46, v46 row_half_mirror row_mask:0xf bank_mask:0xf
    v_rcp_f32 v46, v46
    s_nop 0
    v_mul_f32 v44, v44, v46
    ds_bpermute_b32 v22, v63, v44
    s_cmp_lg_u32 s53, 0
    s_cbranch_scc1 L_oissued
    buffer_load_dwordx4 v[24:27], v17, s[40:43], s12 offen sc1
L_oissued:
    ds_read_b128 v[56:59], v9 offset:128
    s_waitcnt vmcnt(0)
    v_xor_b32 v80, s55, v24
    v_xor_b32 v81, s27, v25
    v_xor_b32 v82, s55, v26
    v_xor_b32 v83, s27, v27
    v_or3_b32 v3, v80, v81, v82
    v_or_b32 v3, v3, v83
    v_and_b32 v3, 0xff, v3
    v_cmp_ne_u32 vcc, 0, v3
    s_cbranch_vccz L_ook
    s_wqm_b64 exec, vcc
    buffer_load_dwordx4 v[24:27], v17, s[40:43], s12 offen sc1
    s_sleep 2
L_opoll:
    s_add_u32 s14, s14, 1
    s_cmp_ge_u32 s14, 2048
    s_cbranch_scc1 rem_12
rem_12_back:
    s_sub_u32 s15, s15, 4
    s_cbranch_scc1 L_end
    buffer_load_dwordx4 v[88:91], v17, s[40:43], s12 offen sc1
    s_waitcnt vmcnt(1)
    v_xor_b32 v80, s55, v24
    v_xor_b32 v81, s27, v25
    v_xor_b32 v82, s55, v26
    v_xor_b32 v83, s27, v27
    v_or3_b32 v3, v80, v81, v82
    v_or_b32 v3, v3, v83
    v_and_b32 v3, 0xff, v3
    v_cmp_ne_u32 vcc, 0, v3
    s_wqm_b64 exec, vcc
    s_cbranch_execz L_odone
    buffer_load_dwordx4 v[24:27], v17, s[40:43], s12 offen sc1
    s_waitcnt vmcnt(1)
    v_xor_b32 v80, s55, v88
    v_xor_b32 v81, s27, v89
    v_xor_b32 v82, s55, v90
    v_xor_b32 v83, s27, v91
    v_or3_b32 v3, v80, v81, v82
    v_or_b32 v3, v3, v83
    v_and_b32 v3, 0xff, v3
    v_cmp_ne_u32 vcc, 0, v3
    s_wqm_b64 exec, vcc
    s_cbranch_execnz L_opoll
L_odone:
    s_mov_b64 exec, -1
L_ook:
    s_waitcnt lgkmcnt(0)
    v_pk_mul_f32 v[80:81], v[80:81], v[22:23] op_sel_hi:[1,0]
    v_pk_mul_f32 v[82:83], v[82:83], v[22:23] op_sel_hi:[1,0]
    v_cvt_pk_bf16_f32 v80, v80, v81
    v_cvt_pk_bf16_f32 v81, v82, v83
    ds_write_b64 v20, v[80:81]
    s_waitcnt lgkmcnt(0)
    s_barrier
    ds_read_b64_tr_b16 v[52:53], v13 offset:16384
    ds_read_b64_tr_b16 v[54:55], v13 offset:20480
    ds_read_b64_tr_b16 v[32:33], v13
    ds_read_b64_tr_b16 v[34:35], v13 offset:4096
    ds_read_b128 v[64:67], v21
    ds_read_b128 v[72:75], v21 offset:2048
    ds_read_b64_tr_b16 v[36:37], v13 offset:8192
    ds_read_b64_tr_b16 v[38:39], v13 offset:12288
    ds_read_b128 v[68:71], v60 offset:1024
    ds_read_b128 v[76:79], v60 offset:3072
    s_waitcnt lgkmcnt(8)
    v_mfma_f32_16x16x32_bf16 v[44:47], v[56:59], v[52:55], 0
    s_waitcnt lgkmcnt(5)
    v_mfma_f32_16x16x32_bf16 v[40:43], v[64:67], v[32:35], 0
    s_waitcnt lgkmcnt(4)
    v_mfma_f32_16x16x32_bf16 v[40:43], v[72:75], v[32:35], v[40:43]
    s_waitcnt lgkmcnt(1)
    v_mfma_f32_16x16x32_bf16 v[40:43], v[68:71], v[36:39], v[40:43]
    s_waitcnt lgkmcnt(0)
    v_mfma_f32_16x16x32_bf16 v[40:43], v[76:79], v[36:39], v[40:43]
    v_bfi_b32 v45, v23, s26, v44
    v_lshlrev_b32 v31, 16, v31
    s_nop 5
    v_add_f32 v40, v40, v41
    v_add_f32 v42, v42, v43
    v_add_f32 v40, v40, v42
    v_bfi_b32 v44, v23, s56, v40
    buffer_store_dwordx2 v[44:45], v18, s[40:43], s13 offen sc1
    s_sleep 18
    buffer_load_dwordx2 v[84:85], v8, s[40:43], s8 offen sc1
    s_waitcnt vmcnt(0)
    v_xor_b32 v56, s55, v84
    v_xor_b32 v57, s27, v85
    v_or_b32 v3, v56, v57
    v_and_b32 v3, 0xff, v3
    v_cmp_ne_u32 vcc, 0, v3
    s_cbranch_vccz L_sok
    s_wqm_b64 exec, vcc
    buffer_load_dwordx2 v[84:85], v8, s[40:43], s8 offen sc1
    s_sleep 2
L_spoll:
    s_sub_u32 s15, s15, 4
    s_cbranch_scc1 L_end
    buffer_load_dwordx2 v[86:87], v8, s[40:43], s8 offen sc1
    s_waitcnt vmcnt(1)
    v_xor_b32 v56, s55, v84
    v_xor_b32 v57, s27, v85
    v_or_b32 v3, v56, v57
    v_and_b32 v3, 0xff, v3
    v_cmp_ne_u32 vcc, 0, v3
    s_wqm_b64 exec, vcc
    s_cbranch_execz L_sdone
    buffer_load_dwordx2 v[84:85], v8, s[40:43], s8 offen sc1
    s_waitcnt vmcnt(1)
    v_xor_b32 v56, s55, v86
    v_xor_b32 v57, s27, v87
    v_or_b32 v3, v56, v57
    v_and_b32 v3, 0xff, v3
    v_cmp_ne_u32 vcc, 0, v3
    s_wqm_b64 exec, vcc
    s_cbranch_execnz L_spoll
L_sdone:
    s_mov_b64 exec, -1
L_sok:
    v_permlane32_swap_b32 v56, v57
    v_add_f32 v56, v56, v57
    v_mov_b32 v58, v56
    s_nop 1
    v_permlane16_swap_b32 v58, v56
    v_add_f32 v56, v56, v58
    s_nop 1
    v_add_f32_dpp v56, v56, v56 row_ror:8 row_mask:0xf bank_mask:0xf
    s_mov_b64 exec, s[30:31]
    ds_write_b32 v62, v56 offset:384
    s_mov_b64 exec, 0xff
    s_waitcnt lgkmcnt(0)
    s_barrier
    s_cmp_eq_u32 s3, 0
    s_cbranch_scc0 L_end
    ds_read_b128 v[64:67], v15 offset:384
    ds_read_b128 v[68:71], v15 offset:400
    ds_read_b128 v[72:75], v15 offset:416
    ds_read_b128 v[76:79], v15 offset:432
    s_waitcnt lgkmcnt(2)
    v_pk_add_f32 v[64:65], v[64:65], v[66:67]
    v_pk_add_f32 v[68:69], v[68:69], v[70:71]
    s_waitcnt lgkmcnt(0)
    v_pk_add_f32 v[72:73], v[72:73], v[74:75]
    v_pk_add_f32 v[76:77], v[76:77], v[78:79]
    v_pk_add_f32 v[64:65], v[64:65], v[68:69]
    v_pk_add_f32 v[72:73], v[72:73], v[76:77]
    s_nop 0
    v_add_f32 v30, v65, v73
    v_add_f32 v56, v64, v72
    v_cvt_pk_bf16_f32 v30, 0, v30
    v_mul_f32 v29, 0xbfb8aa3b, v30
    v_exp_f32 v29, v29
    v_cvt_pk_bf16_f32 v56, 0, v56
    v_add_f32 v29, 1.0, v29
    v_rcp_f32 v29, v29
    s_nop 0
    v_mul_f32 v30, v30, v29
    v_cvt_pk_bf16_f32 v30, 0, v30
    v_mul_f32 v56, v56, v30
    v_cvt_pk_bf16_f32 v56, 0, v56
    v_add_f32 v56, v56, v31
    v_cvt_pk_bf16_f32 v56, v56, v56
    buffer_store_short v56, v11, s[44:47], s58 offen
    s_cmp_eq_u32 s2, 0
    s_cbranch_scc0 L_noep
    s_mov_b64 exec, 1
    buffer_store_dword v4, v5, s[40:43], 0 offen
L_noep:
    s_endpgm
L_mlretry:
    s_add_u32 s53, s53, 1
    s_cmp_ge_u32 s53, 2048
    s_cbranch_scc1 rem_13
rem_13_back:
    s_sub_u32 s15, s15, 4
    s_cbranch_scc1 L_end
    s_sleep 2
    buffer_load_dwordx4 v[44:47], v19, s[40:43], s52 offen sc1
    buffer_load_dwordx4 v[24:27], v17, s[40:43], s12 offen sc1
    s_waitcnt vmcnt(1)
    s_branch L_mlpoll
L_orem:
    buffer_store_dwordx4 v[48:51], v16, s[40:43], s10 offen sc1
    s_waitcnt vmcnt(0)
    s_branch L_oloc
rem_4:
    s_sub_u32 s15, s15, 0x800
    s_cbranch_scc1 L_end
    v_mov_b32 v3, 1
    ds_write_b32 v2, v3 offset:28
    s_waitcnt vmcnt(0) lgkmcnt(0)
    buffer_wbl2 sc1
    s_waitcnt vmcnt(0)
    buffer_inv sc1
    s_waitcnt vmcnt(0)
    s_branch rem_4_back
rem_6:
    s_sub_u32 s15, s15, 0x800
    s_cbranch_scc1 L_end
    v_mov_b32 v3, 1
    ds_write_b32 v2, v3 offset:28
    s_waitcnt vmcnt(0) lgkmcnt(0)
    buffer_wbl2 sc1
    s_waitcnt vmcnt(0)
    buffer_inv sc1
    s_waitcnt vmcnt(0)
    s_branch rem_6_back
rem_7:
    s_sub_u32 s15, s15, 0x800
    s_cbranch_scc1 L_end
    v_mov_b32 v3, 1
    ds_write_b32 v2, v3 offset:28
    s_waitcnt vmcnt(0) lgkmcnt(0)
    buffer_wbl2 sc1
    s_waitcnt vmcnt(0)
    buffer_inv sc1
    s_waitcnt vmcnt(0)
    s_branch rem_7_back
rem_12:
    s_sub_u32 s15, s15, 0x800
    s_cbranch_scc1 L_end
    v_mov_b32 v3, 1
    ds_write_b32 v2, v3 offset:28
    s_waitcnt vmcnt(0) lgkmcnt(0)
    buffer_wbl2 sc1
    s_waitcnt vmcnt(0)
    buffer_inv sc1
    s_waitcnt vmcnt(0)
    s_branch rem_12_back
rem_13:
    s_sub_u32 s15, s15, 0x800
    s_cbranch_scc1 L_end
    v_mov_b32 v3, 1
    ds_write_b32 v2, v3 offset:28
    s_waitcnt vmcnt(0) lgkmcnt(0)
    buffer_wbl2 sc1
    s_waitcnt vmcnt(0)
    buffer_inv sc1
    s_waitcnt vmcnt(0)
    s_branch rem_13_back
L_end:

s_endpgm
.section .rodata,"a"
.p2align 6
.amdhsa_kernel recurrent_scan__sliding_block_cached__swiglu_ffn__decode_kernel
  .amdhsa_next_free_vgpr 128
  .amdhsa_next_free_sgpr 64
  .amdhsa_accum_offset 128
  .amdhsa_group_segment_fixed_size 0
  .amdhsa_kernarg_size 96
  .amdhsa_user_sgpr_count 2
  .amdhsa_user_sgpr_kernarg_segment_ptr 1
  .amdhsa_system_sgpr_workgroup_id_x 1
  .amdhsa_float_denorm_mode_32 3
.end_amdhsa_kernel
```
